```python
import torch

def _softmax(x, axis=-1):
    return torch.softmax(x, dim=axis)
def _gelu(x):
    return torch.nn.functional.gelu(x, approximate="tanh")
def _silu(x):
    return torch.nn.functional.silu(x)
def _sigmoid(x):
    return torch.sigmoid(x)
def _layernorm(x, axis=-1, eps=1e-5):
    m = x.mean(dim=axis, keepdim=True)
    v = x.var(dim=axis, keepdim=True, unbiased=False)
    return (x - m) / torch.sqrt(v + eps)
def _scatter_add(tgt, idx, src, axis=0):
    return tgt.clone().index_add_(axis, idx, src)
def _segment_sum(src, seg, n):
    out = torch.zeros((n,) + src.shape[1:], dtype=src.dtype)
    return out.index_add_(0, seg, src)
def _pad(x, pw):
    flat = tuple(v for pair in reversed(pw) for v in pair)
    return torch.nn.functional.pad(x, flat)

kernel_name = 'standalone__mha_softmax__decode'

def setup_inputs():

    _w = (lambda a: (lambda t: t.to(torch.bfloat16) if t.is_floating_point() else t)(torch.as_tensor(a)))
    B, H, Sq, Sk, D = 2, 32, 1, 4096, 128
    return {
        "q": _w((lambda *s: torch.randn(*s, dtype=torch.bfloat16) * 0.8)(B, H, Sq, D)),
        "k": _w((lambda *s: torch.randn(*s, dtype=torch.bfloat16) * 0.8)(B, H, Sk, D)),
        "v": _w((lambda *s: torch.randn(*s, dtype=torch.bfloat16) * 0.05)(B, H, Sk, D)),
    }

def reference(q, k, v):
    scale = q.shape[-1] ** -0.5
    scores = torch.einsum("bhqd,bhkd->bhqk", q, k) * scale
    p = _softmax(scores, axis=-1)
    return torch.einsum("bhqk,bhkd->bhqd", p, v)
```

```asm
; @launch grid=(256,1,1) block=(320,1,1) lds=90112
.amdgcn_target "amdgcn-amd-amdhsa--gfx950"
.text
.globl standalone__mha_softmax__decode_kernel
.p2align 8
.type standalone__mha_softmax__decode_kernel,@function
standalone__mha_softmax__decode_kernel:
    s_load_dwordx2 s[8:9], s[0:1], 8
    s_load_dwordx2 s[4:5], s[0:1], 0
    s_cmpk_ge_u32 s2, 256
    s_cbranch_scc1 L_end
    v_readfirstlane_b32 s26, v0
    s_getpc_b64 s[28:29]
L_pc:
    s_cmpk_lg_u32 s26, 256
    s_cbranch_scc1 L_nopf
    s_lshr_b32 s3, s2, 3
    s_mul_i32 s3, s3, 192
    s_min_u32 s3, s3, L_global-L_pc
    s_load_dword s30, s[28:29], s3 offset:0
    s_load_dword s30, s[28:29], s3 offset:64
    s_load_dword s30, s[28:29], s3 offset:128
L_nopf:
    s_mov_b32 s40, 0x230
    s_mov_b32 s41, 0x2897004
    s_mov_b32 s42, 0x2f32e30
    s_mov_b32 s43, 0x72ee24
    s_bitcmp1_b32 s2, 2
    s_cselect_b32 s40, 0x1bceb19, s40
    s_cselect_b32 s41, 0x3359b3c, s41
    s_cselect_b32 s42, 0x3477518, s42
    s_cselect_b32 s43, 0x1ce051c, s43
    s_bitcmp1_b32 s2, 1
    s_cselect_b64 s[40:41], s[42:43], s[40:41]
    s_bitcmp1_b32 s2, 0
    s_cselect_b32 s35, s41, s40
    s_andn2_b32 s24, s35, 63
    s_bitcmp1_b32 s2, 3
    s_cselect_b32 s3, 0x1f5f700, 0
    s_xor_b32 s24, s24, s3
    s_bitcmp1_b32 s2, 4
    s_cselect_b32 s3, 0x1d6bf00, 0
    s_xor_b32 s24, s24, s3
    s_bitcmp1_b32 s2, 5
    s_cselect_b32 s3, 0x123ca00, 0
    s_xor_b32 s24, s24, s3
    s_bitcmp1_b32 s2, 6
    s_cselect_b32 s3, 0x1c100, 0
    s_xor_b32 s24, s24, s3
    s_bitcmp1_b32 s2, 7
    s_cselect_b32 s3, 0x10000, 0
    s_xor_b32 s24, s24, s3
    s_lshr_b32 s20, s24, 20
    v_lshlrev_b32 v3, 4, v0
    v_and_b32 v34, 0xf0, v3
    s_lshl_b32 s3, s20, 8
    v_or_b32 v2, s3, v34
    s_cmpk_eq_u32 s26, 256
    s_cbranch_scc1 L_fw
    s_mov_b32 s10, 0x4000000
    s_mov_b32 s11, 0x20000
    v_mov_b32 v35, s24
    v_bfe_i32 v3, v0, 0, 1
    v_and_b32 v1, 0x3bf00, v3
    v_xor_b32 v35, v35, v1
    v_bfe_i32 v3, v0, 1, 1
    v_and_b32 v1, 0x8b000, v3
    v_xor_b32 v35, v35, v1
    v_bfe_i32 v3, v0, 2, 1
    v_and_b32 v1, 0x80000, v3
    v_xor_b32 v35, v35, v1
    v_bfe_i32 v3, v0, 3, 1
    v_and_b32 v1, 0x4ef00, v3
    v_xor_b32 v35, v35, v1
    v_bfe_i32 v3, v0, 4, 1
    v_and_b32 v1, 0x8a800, v3
    v_xor_b32 v35, v35, v1
    v_and_b32 v3, 0x89000, v3
    v_xor_b32 v34, v34, v3
    v_bfe_i32 v3, v0, 5, 1
    v_and_b32 v1, 0x69c00, v3
    v_xor_b32 v35, v35, v1
    v_and_b32 v3, 0x8b200, v3
    v_xor_b32 v34, v34, v3
    v_bfe_i32 v3, v0, 6, 1
    v_and_b32 v3, 0x19700, v3
    v_xor_b32 v34, v34, v3
    v_bfe_i32 v3, v0, 7, 1
    v_and_b32 v3, 0xa4f00, v3
    v_xor_b32 v34, v34, v3
    s_bitcmp1_b32 s2, 5
    s_cselect_b32 s3, 4, 0
    s_add_u32 s35, s35, s3
    s_bitcmp1_b32 s26, 6
    s_addc_u32 s35, s35, 0
    s_bitcmp1_b32 s26, 7
    s_cselect_b32 s3, 2, 0
    s_add_u32 s35, s35, s3
    v_readlane_b32 s40, v35, s35
    s_add_u32 s35, s35, 1
    v_readlane_b32 s41, v35, s35
    s_add_u32 s35, s35, 1
    v_readlane_b32 s34, v35, s35
    s_add_u32 s35, s35, 1
    v_xor_b32 v104, s40, v34
    v_xor_b32 v105, s41, v34
    s_waitcnt lgkmcnt(0)
    buffer_load_dwordx4 v[40:43], v104, s[8:11], 0 offen nt
    s_load_dwordx8 s[12:19], s[0:1], 16
    global_load_dwordx4 v[4:7], v2, s[4:5]
    s_mov_b32 s28, 0x22222222
    buffer_load_dwordx4 v[44:47], v105, s[8:11], 0 offen nt
    v_xor_b32 v36, s34, v34
    v_readlane_b32 s34, v35, s35
    s_add_u32 s35, s35, 1
    buffer_load_dwordx4 v[48:51], v36, s[8:11], 0 offen nt
    v_xor_b32 v37, s34, v34
    v_readlane_b32 s34, v35, s35
    s_add_u32 s35, s35, 1
    buffer_load_dwordx4 v[52:55], v37, s[8:11], 0 offen nt
    v_xor_b32 v36, s34, v34
    v_readlane_b32 s34, v35, s35
    s_add_u32 s35, s35, 1
    buffer_load_dwordx4 v[56:59], v36, s[8:11], 0 offen nt
    v_xor_b32 v37, s34, v34
    v_readlane_b32 s34, v35, s35
    s_add_u32 s35, s35, 1
    buffer_load_dwordx4 v[60:63], v37, s[8:11], 0 offen nt
    v_xor_b32 v36, s34, v34
    v_readlane_b32 s34, v35, s35
    s_add_u32 s35, s35, 1
    s_mov_b32 s29, 0x22222222
    s_mov_b32 s30, 0x44444444
    s_mov_b32 s31, 0x44444444
    s_mov_b32 s32, 0x88888888
    s_mov_b32 s33, 0x88888888
    s_mov_b32 s23, 0xffff0000
    s_mov_b32 s25, 0
    s_mov_b32 s22, 0x3e0293ee
    v_mov_b32 v31, 0xff800000
    v_and_b32 v30, 63, v0
    v_lshlrev_b32 v30, 2, v30
    s_lshl_b32 s3, s26, 4
    v_or_b32 v30, s3, v30
    v_mov_b32 v8, 0
    v_mov_b32 v9, 0
    v_mov_b32 v10, 0
    v_mov_b32 v11, 0
    v_mov_b32 v3, 0x0c0c0302
    v_mov_b32 v1, 0x03020c0c
    v_cndmask_b32 v3, v3, v1, s[28:29]
    v_mov_b32 v1, 0x0c0c0100
    v_cndmask_b32 v3, v3, v1, s[30:31]
    v_mov_b32 v1, 0x01000c0c
    v_cndmask_b32 v3, v3, v1, s[32:33]
    v_mov_b32 v12, 0x0c0c0c0c
    v_mov_b32 v13, 0x0c0c0c0c
    v_mov_b32 v14, 0x0c0c0c0c
    v_mov_b32 v15, 0x0c0c0c0c
    v_mov_b32_dpp v12, v3 quad_perm:[0,1,2,3] row_mask:0xf bank_mask:0x1
    v_mov_b32_dpp v13, v3 quad_perm:[0,1,2,3] row_mask:0xf bank_mask:0x2
    v_mov_b32_dpp v14, v3 quad_perm:[0,1,2,3] row_mask:0xf bank_mask:0x4
    v_mov_b32_dpp v15, v3 quad_perm:[0,1,2,3] row_mask:0xf bank_mask:0x8
    s_waitcnt lgkmcnt(0)
L_k:
    s_waitcnt vmcnt(5)
    buffer_load_dwordx4 v[64:67], v36, s[8:11], 0 offen nt
    v_xor_b32 v37, s34, v34
    v_readlane_b32 s34, v35, s35
    s_add_u32 s35, s35, 1
    v_dot2_f32_bf16 v16, v40, v4, 0
    v_dot2_f32_bf16 v16, v41, v5, v16
    v_dot2_f32_bf16 v16, v42, v6, v16
    v_dot2_f32_bf16 v16, v43, v7, v16
    s_waitcnt vmcnt(5)
    buffer_load_dwordx4 v[68:71], v37, s[8:11], 0 offen nt
    v_xor_b32 v36, s34, v34
    v_readlane_b32 s34, v35, s35
    s_add_u32 s35, s35, 1
    v_dot2_f32_bf16 v17, v44, v4, 0
    v_dot2_f32_bf16 v17, v45, v5, v17
    v_dot2_f32_bf16 v17, v46, v6, v17
    v_dot2_f32_bf16 v17, v47, v7, v17
    s_waitcnt vmcnt(5)
    buffer_load_dwordx4 v[72:75], v36, s[8:11], 0 offen nt
    v_xor_b32 v37, s34, v34
    v_readlane_b32 s34, v35, s35
    s_add_u32 s35, s35, 1
    v_dot2_f32_bf16 v18, v48, v4, 0
    v_dot2_f32_bf16 v18, v49, v5, v18
    v_dot2_f32_bf16 v18, v50, v6, v18
    v_dot2_f32_bf16 v18, v51, v7, v18
    s_waitcnt vmcnt(5)
    buffer_load_dwordx4 v[76:79], v37, s[8:11], 0 offen nt
    v_xor_b32 v36, s34, v34
    v_readlane_b32 s34, v35, s35
    s_add_u32 s35, s35, 1
    v_dot2_f32_bf16 v19, v52, v4, 0
    v_dot2_f32_bf16 v19, v53, v5, v19
    v_dot2_f32_bf16 v19, v54, v6, v19
    v_dot2_f32_bf16 v19, v55, v7, v19
    s_waitcnt vmcnt(5)
    buffer_load_dwordx4 v[80:83], v36, s[8:11], 0 offen nt
    v_xor_b32 v37, s34, v34
    v_readlane_b32 s34, v35, s35
    s_add_u32 s35, s35, 1
    v_dot2_f32_bf16 v20, v56, v4, 0
    v_dot2_f32_bf16 v20, v57, v5, v20
    v_dot2_f32_bf16 v20, v58, v6, v20
    v_dot2_f32_bf16 v20, v59, v7, v20
    v_add_f32_dpp v32, v16, v16 row_ror:8 row_mask:0xf bank_mask:0x3
    v_add_f32_dpp v33, v17, v17 row_ror:8 row_mask:0xf bank_mask:0x3
    v_add_f32_dpp v32, v18, v18 row_ror:8 row_mask:0xf bank_mask:0xc
    v_add_f32_dpp v33, v19, v19 row_ror:8 row_mask:0xf bank_mask:0xc
    s_waitcnt vmcnt(5)
    buffer_load_dwordx4 v[84:87], v37, s[8:11], 0 offen nt
    v_xor_b32 v36, s34, v34
    v_readlane_b32 s34, v35, s35
    s_add_u32 s35, s35, 1
    v_dot2_f32_bf16 v21, v60, v4, 0
    v_dot2_f32_bf16 v21, v61, v5, v21
    v_dot2_f32_bf16 v21, v62, v6, v21
    v_dot2_f32_bf16 v21, v63, v7, v21
    v_add_f32_dpp v24, v32, v32 row_shl:4 row_mask:0xf bank_mask:0x5
    v_add_f32_dpp v24, v33, v33 row_shr:4 row_mask:0xf bank_mask:0xa
    s_waitcnt vmcnt(5)
    buffer_load_dwordx4 v[88:91], v36, s[8:11], 0 offen nt
    v_xor_b32 v37, s34, v34
    v_readlane_b32 s34, v35, s35
    s_add_u32 s35, s35, 1
    v_dot2_f32_bf16 v22, v64, v4, 0
    v_dot2_f32_bf16 v22, v65, v5, v22
    v_dot2_f32_bf16 v22, v66, v6, v22
    v_dot2_f32_bf16 v22, v67, v7, v22
    v_add_f32_dpp v24, v24, v24 quad_perm:[1,0,3,2] row_mask:0xf bank_mask:0xf
    s_waitcnt vmcnt(5)
    buffer_load_dwordx4 v[92:95], v37, s[8:11], 0 offen nt
    v_xor_b32 v36, s34, v34
    v_readlane_b32 s34, v35, s35
    s_add_u32 s35, s35, 1
    v_dot2_f32_bf16 v23, v68, v4, 0
    v_dot2_f32_bf16 v23, v69, v5, v23
    v_dot2_f32_bf16 v23, v70, v6, v23
    v_dot2_f32_bf16 v23, v71, v7, v23
    v_add_f32_dpp v24, v24, v24 quad_perm:[2,3,0,1] row_mask:0xf bank_mask:0xf
    s_waitcnt vmcnt(5)
    buffer_load_dwordx4 v[96:99], v36, s[8:11], 0 offen nt
    v_xor_b32 v37, s34, v34
    v_readlane_b32 s34, v35, s35
    s_add_u32 s35, s35, 1
    v_dot2_f32_bf16 v16, v72, v4, 0
    v_dot2_f32_bf16 v16, v73, v5, v16
    v_dot2_f32_bf16 v16, v74, v6, v16
    v_dot2_f32_bf16 v16, v75, v7, v16
    v_add_f32_dpp v32, v20, v20 row_ror:8 row_mask:0xf bank_mask:0x3
    v_add_f32_dpp v33, v21, v21 row_ror:8 row_mask:0xf bank_mask:0x3
    v_add_f32_dpp v32, v22, v22 row_ror:8 row_mask:0xf bank_mask:0xc
    v_add_f32_dpp v33, v23, v23 row_ror:8 row_mask:0xf bank_mask:0xc
    s_waitcnt vmcnt(5)
    buffer_load_dwordx4 v[100:103], v37, s[8:11], 0 offen nt
    v_xor_b32 v36, s34, v34
    v_readlane_b32 s34, v35, s35
    s_add_u32 s35, s35, 1
    v_dot2_f32_bf16 v17, v76, v4, 0
    v_dot2_f32_bf16 v17, v77, v5, v17
    v_dot2_f32_bf16 v17, v78, v6, v17
    v_dot2_f32_bf16 v17, v79, v7, v17
    v_add_f32_dpp v25, v32, v32 row_shl:4 row_mask:0xf bank_mask:0x5
    v_add_f32_dpp v25, v33, v33 row_shr:4 row_mask:0xf bank_mask:0xa
    s_cmp_eq_u32 s25, 3
    s_cselect_b32 s8, s12, s8
    s_cselect_b32 s9, s13, s9
    s_waitcnt vmcnt(5)
    buffer_load_dwordx4 v[40:43], v36, s[8:11], 0 offen nt
    v_xor_b32 v37, s34, v34
    v_readlane_b32 s34, v35, s35
    s_add_u32 s35, s35, 1
    v_dot2_f32_bf16 v18, v80, v4, 0
    v_dot2_f32_bf16 v18, v81, v5, v18
    v_dot2_f32_bf16 v18, v82, v6, v18
    v_dot2_f32_bf16 v18, v83, v7, v18
    v_add_f32_dpp v25, v25, v25 quad_perm:[1,0,3,2] row_mask:0xf bank_mask:0xf
    s_waitcnt vmcnt(5)
    buffer_load_dwordx4 v[44:47], v37, s[8:11], 0 offen nt
    v_xor_b32 v36, s34, v34
    v_readlane_b32 s34, v35, s35
    s_add_u32 s35, s35, 1
    v_dot2_f32_bf16 v19, v84, v4, 0
    v_dot2_f32_bf16 v19, v85, v5, v19
    v_dot2_f32_bf16 v19, v86, v6, v19
    v_dot2_f32_bf16 v19, v87, v7, v19
    v_add_f32_dpp v25, v25, v25 quad_perm:[2,3,0,1] row_mask:0xf bank_mask:0xf
    v_cndmask_b32 v28, v24, v25, s[28:29]
    s_waitcnt vmcnt(5)
    buffer_load_dwordx4 v[48:51], v36, s[8:11], 0 offen nt
    v_xor_b32 v37, s34, v34
    v_readlane_b32 s34, v35, s35
    s_add_u32 s35, s35, 1
    v_dot2_f32_bf16 v20, v88, v4, 0
    v_dot2_f32_bf16 v20, v89, v5, v20
    v_dot2_f32_bf16 v20, v90, v6, v20
    v_dot2_f32_bf16 v20, v91, v7, v20
    v_add_f32_dpp v32, v16, v16 row_ror:8 row_mask:0xf bank_mask:0x3
    v_add_f32_dpp v33, v17, v17 row_ror:8 row_mask:0xf bank_mask:0x3
    v_add_f32_dpp v32, v18, v18 row_ror:8 row_mask:0xf bank_mask:0xc
    v_add_f32_dpp v33, v19, v19 row_ror:8 row_mask:0xf bank_mask:0xc
    s_waitcnt vmcnt(5)
    buffer_load_dwordx4 v[52:55], v37, s[8:11], 0 offen nt
    v_xor_b32 v36, s34, v34
    v_readlane_b32 s34, v35, s35
    s_add_u32 s35, s35, 1
    v_dot2_f32_bf16 v21, v92, v4, 0
    v_dot2_f32_bf16 v21, v93, v5, v21
    v_dot2_f32_bf16 v21, v94, v6, v21
    v_dot2_f32_bf16 v21, v95, v7, v21
    v_add_f32_dpp v26, v32, v32 row_shl:4 row_mask:0xf bank_mask:0x5
    v_add_f32_dpp v26, v33, v33 row_shr:4 row_mask:0xf bank_mask:0xa
    s_waitcnt vmcnt(5)
    buffer_load_dwordx4 v[56:59], v36, s[8:11], 0 offen nt
    v_xor_b32 v37, s34, v34
    v_readlane_b32 s34, v35, s35
    s_add_u32 s35, s35, 1
    v_dot2_f32_bf16 v22, v96, v4, 0
    v_dot2_f32_bf16 v22, v97, v5, v22
    v_dot2_f32_bf16 v22, v98, v6, v22
    v_dot2_f32_bf16 v22, v99, v7, v22
    v_add_f32_dpp v26, v26, v26 quad_perm:[1,0,3,2] row_mask:0xf bank_mask:0xf
    s_waitcnt vmcnt(5)
    buffer_load_dwordx4 v[60:63], v37, s[8:11], 0 offen nt
    v_xor_b32 v36, s34, v34
    v_readlane_b32 s34, v35, s35
    s_add_u32 s35, s35, 1
    v_dot2_f32_bf16 v23, v100, v4, 0
    v_dot2_f32_bf16 v23, v101, v5, v23
    v_dot2_f32_bf16 v23, v102, v6, v23
    v_dot2_f32_bf16 v23, v103, v7, v23
    v_add_f32_dpp v26, v26, v26 quad_perm:[2,3,0,1] row_mask:0xf bank_mask:0xf
    v_cndmask_b32 v28, v28, v26, s[30:31]
    v_add_f32_dpp v32, v20, v20 row_ror:8 row_mask:0xf bank_mask:0x3
    v_add_f32_dpp v33, v21, v21 row_ror:8 row_mask:0xf bank_mask:0x3
    v_add_f32_dpp v32, v22, v22 row_ror:8 row_mask:0xf bank_mask:0xc
    v_add_f32_dpp v33, v23, v23 row_ror:8 row_mask:0xf bank_mask:0xc
    s_add_u32 s25, s25, 1
    v_add_f32_dpp v27, v32, v32 row_shl:4 row_mask:0xf bank_mask:0x5
    v_add_f32_dpp v27, v33, v33 row_shr:4 row_mask:0xf bank_mask:0xa
    s_cmp_lt_u32 s25, 4
    s_nop 0
    v_add_f32_dpp v27, v27, v27 quad_perm:[1,0,3,2] row_mask:0xf bank_mask:0xf
    s_nop 1
    v_add_f32_dpp v27, v27, v27 quad_perm:[2,3,0,1] row_mask:0xf bank_mask:0xf
    v_cndmask_b32 v28, v28, v27, s[32:33]
    ds_write_b32 v30, v28 offset:0
    v_max_f32 v31, v31, v28
    v_add_u32 v30, 256, v30
    s_cbranch_scc1 L_k
    v_subrev_u32 v30, 1024, v30
    ds_read_b32 v29, v30 offset:0
    v_max_f32_dpp v31, v31, v31 row_ror:8 row_mask:0xf bank_mask:0xf
    s_lshr_b32 s3, s26, 4
    v_mov_b32 v1, s3
    v_max_f32_dpp v31, v31, v31 row_ror:4 row_mask:0xf bank_mask:0xf
    s_nop 1
    v_max_f32_dpp v31, v31, v31 row_ror:2 row_mask:0xf bank_mask:0xf
    s_nop 1
    v_max_f32_dpp v31, v31, v31 row_ror:1 row_mask:0xf bank_mask:0xf
    s_waitcnt vmcnt(5)
    buffer_load_dwordx4 v[64:67], v36, s[8:11], 0 offen nt
    v_xor_b32 v37, s34, v34
    v_readlane_b32 s34, v35, s35
    s_add_u32 s35, s35, 1
    v_mov_b32 v3, v31
    s_nop 1
    v_permlane32_swap_b32 v3, v31
    v_max_f32 v31, v31, v3
    v_mov_b32 v3, v31
    s_nop 1
    v_permlane16_swap_b32 v3, v31
    v_max_f32 v31, v31, v3
    v_mul_f32 v31, s22, v31
    ds_write_b32 v1, v31 offset:6144
    s_waitcnt vmcnt(5)
    buffer_load_dwordx4 v[68:71], v37, s[8:11], 0 offen nt
    v_xor_b32 v36, s34, v34
    v_readlane_b32 s34, v35, s35
    s_add_u32 s35, s35, 1
    v_lshlrev_b32 v1, 3, v0
    s_mov_b32 s25, 1
    s_waitcnt lgkmcnt(0)
    s_barrier
    v_fma_f32 v29, v29, s22, -v31
    v_exp_f32 v29, v29
    s_nop 0
    v_and_b32 v3, s23, v29
    v_sub_f32 v29, v29, v3
    v_cvt_pk_bf16_f32 v28, v29, v3
    s_nop 1
L_v:
    v_mov_b32_dpp v32, v28 row_newbcast:0 row_mask:0xf bank_mask:0xf
    v_perm_b32 v16, v32, v32, v12
    v_perm_b32 v17, v32, v32, v13
    v_perm_b32 v18, v32, v32, v14
    v_perm_b32 v19, v32, v32, v15
    s_waitcnt vmcnt(5)
    buffer_load_dwordx4 v[72:75], v36, s[8:11], 0 offen nt
    v_xor_b32 v37, s34, v34
    v_readlane_b32 s34, v35, s35
    s_add_u32 s35, s35, 1
    v_mfma_f32_16x16x32_bf16 v[8:11], v[16:19], v[40:43], v[8:11]
    v_mov_b32_dpp v33, v28 row_newbcast:4 row_mask:0xf bank_mask:0xf
    v_perm_b32 v20, v33, v33, v12
    v_perm_b32 v21, v33, v33, v13
    v_perm_b32 v22, v33, v33, v14
    v_perm_b32 v23, v33, v33, v15
    s_waitcnt vmcnt(5)
    buffer_load_dwordx4 v[76:79], v37, s[8:11], 0 offen nt
    v_xor_b32 v36, s34, v34
    v_readlane_b32 s34, v35, s35
    s_add_u32 s35, s35, 1
    v_mfma_f32_16x16x32_bf16 v[8:11], v[20:23], v[44:47], v[8:11]
    v_mov_b32_dpp v32, v28 row_newbcast:8 row_mask:0xf bank_mask:0xf
    v_perm_b32 v16, v32, v32, v12
    v_perm_b32 v17, v32, v32, v13
    v_perm_b32 v18, v32, v32, v14
    v_perm_b32 v19, v32, v32, v15
    s_waitcnt vmcnt(5)
    buffer_load_dwordx4 v[80:83], v36, s[8:11], 0 offen nt
    v_xor_b32 v37, s34, v34
    v_readlane_b32 s34, v35, s35
    s_add_u32 s35, s35, 1
    v_mfma_f32_16x16x32_bf16 v[8:11], v[16:19], v[48:51], v[8:11]
    ds_read_b32 v29, v30 offset:256
    v_mov_b32_dpp v33, v28 row_newbcast:12 row_mask:0xf bank_mask:0xf
    v_perm_b32 v20, v33, v33, v12
    v_perm_b32 v21, v33, v33, v13
    v_perm_b32 v22, v33, v33, v14
    v_perm_b32 v23, v33, v33, v15
    s_waitcnt vmcnt(5)
    buffer_load_dwordx4 v[84:87], v37, s[8:11], 0 offen nt
    v_xor_b32 v36, s34, v34
    v_readlane_b32 s34, v35, s35
    s_add_u32 s35, s35, 1
    v_mfma_f32_16x16x32_bf16 v[8:11], v[20:23], v[52:55], v[8:11]
    v_mov_b32_dpp v32, v28 row_newbcast:1 row_mask:0xf bank_mask:0xf
    v_perm_b32 v16, v32, v32, v12
    v_perm_b32 v17, v32, v32, v13
    v_perm_b32 v18, v32, v32, v14
    v_perm_b32 v19, v32, v32, v15
    s_waitcnt vmcnt(5)
    buffer_load_dwordx4 v[88:91], v36, s[8:11], 0 offen nt
    v_xor_b32 v37, s34, v34
    v_readlane_b32 s34, v35, s35
    s_add_u32 s35, s35, 1
    v_mfma_f32_16x16x32_bf16 v[8:11], v[16:19], v[56:59], v[8:11]
    v_mov_b32_dpp v33, v28 row_newbcast:5 row_mask:0xf bank_mask:0xf
    v_perm_b32 v20, v33, v33, v12
    v_perm_b32 v21, v33, v33, v13
    v_perm_b32 v22, v33, v33, v14
    v_perm_b32 v23, v33, v33, v15
    s_waitcnt vmcnt(5)
    buffer_load_dwordx4 v[92:95], v37, s[8:11], 0 offen nt
    v_xor_b32 v36, s34, v34
    v_readlane_b32 s34, v35, s35
    s_add_u32 s35, s35, 1
    v_mfma_f32_16x16x32_bf16 v[8:11], v[20:23], v[60:63], v[8:11]
    v_mov_b32_dpp v32, v28 row_newbcast:9 row_mask:0xf bank_mask:0xf
    v_perm_b32 v16, v32, v32, v12
    v_perm_b32 v17, v32, v32, v13
    v_perm_b32 v18, v32, v32, v14
    v_perm_b32 v19, v32, v32, v15
    s_waitcnt vmcnt(5)
    buffer_load_dwordx4 v[96:99], v36, s[8:11], 0 offen nt
    v_xor_b32 v37, s34, v34
    v_readlane_b32 s34, v35, s35
    s_add_u32 s35, s35, 1
    v_mfma_f32_16x16x32_bf16 v[8:11], v[16:19], v[64:67], v[8:11]
    v_mov_b32_dpp v33, v28 row_newbcast:13 row_mask:0xf bank_mask:0xf
    v_perm_b32 v20, v33, v33, v12
    v_perm_b32 v21, v33, v33, v13
    v_perm_b32 v22, v33, v33, v14
    v_perm_b32 v23, v33, v33, v15
    s_waitcnt vmcnt(5)
    buffer_load_dwordx4 v[100:103], v37, s[8:11], 0 offen nt
    v_xor_b32 v36, s34, v34
    v_readlane_b32 s34, v35, s35
    s_add_u32 s35, s35, 1
    v_mfma_f32_16x16x32_bf16 v[8:11], v[20:23], v[68:71], v[8:11]
    v_mov_b32_dpp v32, v28 row_newbcast:2 row_mask:0xf bank_mask:0xf
    v_perm_b32 v16, v32, v32, v12
    v_perm_b32 v17, v32, v32, v13
    v_perm_b32 v18, v32, v32, v14
    v_perm_b32 v19, v32, v32, v15
    s_waitcnt vmcnt(5)
    buffer_load_dwordx4 v[40:43], v36, s[8:11], 0 offen nt
    v_xor_b32 v37, s34, v34
    v_readlane_b32 s34, v35, s35
    s_add_u32 s35, s35, 1
    v_mfma_f32_16x16x32_bf16 v[8:11], v[16:19], v[72:75], v[8:11]
    s_waitcnt lgkmcnt(0)
    v_fma_f32 v29, v29, s22, -v31
    v_exp_f32 v29, v29
    v_mov_b32_dpp v33, v28 row_newbcast:6 row_mask:0xf bank_mask:0xf
    v_perm_b32 v20, v33, v33, v12
    v_perm_b32 v21, v33, v33, v13
    v_perm_b32 v22, v33, v33, v14
    v_perm_b32 v23, v33, v33, v15
    s_waitcnt vmcnt(5)
    buffer_load_dwordx4 v[44:47], v37, s[8:11], 0 offen nt
    v_xor_b32 v36, s34, v34
    v_readlane_b32 s34, v35, s35
    s_add_u32 s35, s35, 1
    v_mfma_f32_16x16x32_bf16 v[8:11], v[20:23], v[76:79], v[8:11]
    v_mov_b32_dpp v32, v28 row_newbcast:10 row_mask:0xf bank_mask:0xf
    v_perm_b32 v16, v32, v32, v12
    v_perm_b32 v17, v32, v32, v13
    v_perm_b32 v18, v32, v32, v14
    v_perm_b32 v19, v32, v32, v15
    s_waitcnt vmcnt(5)
    buffer_load_dwordx4 v[48:51], v36, s[8:11], 0 offen nt
    v_xor_b32 v37, s34, v34
    v_readlane_b32 s34, v35, s35
    s_add_u32 s35, s35, 1
    v_mfma_f32_16x16x32_bf16 v[8:11], v[16:19], v[80:83], v[8:11]
    v_and_b32 v3, s23, v29
    v_sub_f32 v29, v29, v3
    v_mov_b32_dpp v33, v28 row_newbcast:14 row_mask:0xf bank_mask:0xf
    v_perm_b32 v20, v33, v33, v12
    v_perm_b32 v21, v33, v33, v13
    v_perm_b32 v22, v33, v33, v14
    v_perm_b32 v23, v33, v33, v15
    s_waitcnt vmcnt(5)
    buffer_load_dwordx4 v[52:55], v37, s[8:11], 0 offen nt
    v_xor_b32 v36, s34, v34
    v_readlane_b32 s34, v35, s35
    s_add_u32 s35, s35, 1
    v_mfma_f32_16x16x32_bf16 v[8:11], v[20:23], v[84:87], v[8:11]
    v_mov_b32_dpp v32, v28 row_newbcast:3 row_mask:0xf bank_mask:0xf
    v_perm_b32 v16, v32, v32, v12
    v_perm_b32 v17, v32, v32, v13
    v_perm_b32 v18, v32, v32, v14
    v_perm_b32 v19, v32, v32, v15
    s_waitcnt vmcnt(5)
    buffer_load_dwordx4 v[56:59], v36, s[8:11], 0 offen nt
    v_xor_b32 v37, s34, v34
    v_readlane_b32 s34, v35, s35
    s_add_u32 s35, s35, 1
    v_mfma_f32_16x16x32_bf16 v[8:11], v[16:19], v[88:91], v[8:11]
    v_add_u32 v30, 256, v30
    v_mov_b32_dpp v33, v28 row_newbcast:7 row_mask:0xf bank_mask:0xf
    v_perm_b32 v20, v33, v33, v12
    v_perm_b32 v21, v33, v33, v13
    v_perm_b32 v22, v33, v33, v14
    v_perm_b32 v23, v33, v33, v15
    s_waitcnt vmcnt(5)
    buffer_load_dwordx4 v[60:63], v37, s[8:11], 0 offen nt
    v_xor_b32 v36, s34, v34
    v_readlane_b32 s34, v35, s35
    s_add_u32 s35, s35, 1
    v_mfma_f32_16x16x32_bf16 v[8:11], v[20:23], v[92:95], v[8:11]
    v_mov_b32_dpp v32, v28 row_newbcast:11 row_mask:0xf bank_mask:0xf
    v_perm_b32 v16, v32, v32, v12
    v_perm_b32 v17, v32, v32, v13
    v_perm_b32 v18, v32, v32, v14
    v_perm_b32 v19, v32, v32, v15
    s_waitcnt vmcnt(5)
    buffer_load_dwordx4 v[64:67], v36, s[8:11], 0 offen nt
    v_xor_b32 v37, s34, v34
    v_readlane_b32 s34, v35, s35
    s_add_u32 s35, s35, 1
    v_mfma_f32_16x16x32_bf16 v[8:11], v[16:19], v[96:99], v[8:11]
    v_mov_b32_dpp v33, v28 row_newbcast:15 row_mask:0xf bank_mask:0xf
    v_perm_b32 v20, v33, v33, v12
    v_perm_b32 v21, v33, v33, v13
    v_perm_b32 v22, v33, v33, v14
    v_perm_b32 v23, v33, v33, v15
    v_cvt_pk_bf16_f32 v28, v29, v3
    s_waitcnt vmcnt(5)
    buffer_load_dwordx4 v[68:71], v37, s[8:11], 0 offen nt
    v_xor_b32 v36, s34, v34
    v_readlane_b32 s34, v35, s35
    s_add_u32 s35, s35, 1
    s_add_u32 s25, s25, 1
    s_cmp_lt_u32 s25, 4
    v_mfma_f32_16x16x32_bf16 v[8:11], v[20:23], v[100:103], v[8:11]
    s_cbranch_scc1 L_v
    v_mov_b32_dpp v32, v28 row_newbcast:0 row_mask:0xf bank_mask:0xf
    v_perm_b32 v104, v32, v32, v12
    v_perm_b32 v105, v32, v32, v13
    v_perm_b32 v106, v32, v32, v14
    v_perm_b32 v107, v32, v32, v15
    v_mov_b32_dpp v33, v28 row_newbcast:4 row_mask:0xf bank_mask:0xf
    v_perm_b32 v108, v33, v33, v12
    v_perm_b32 v109, v33, v33, v13
    v_perm_b32 v110, v33, v33, v14
    v_perm_b32 v111, v33, v33, v15
    s_waitcnt vmcnt(5)
    buffer_load_dwordx4 v[72:75], v36, s[8:11], 0 offen nt
    v_xor_b32 v37, s34, v34
    v_readlane_b32 s34, v35, s35
    s_add_u32 s35, s35, 1
    v_mfma_f32_16x16x32_bf16 v[8:11], v[104:107], v[40:43], v[8:11]
    v_mov_b32_dpp v32, v28 row_newbcast:8 row_mask:0xf bank_mask:0xf
    v_perm_b32 v112, v32, v32, v12
    v_perm_b32 v113, v32, v32, v13
    v_perm_b32 v114, v32, v32, v14
    v_perm_b32 v115, v32, v32, v15
    v_mov_b32_dpp v33, v28 row_newbcast:12 row_mask:0xf bank_mask:0xf
    v_perm_b32 v116, v33, v33, v12
    v_perm_b32 v117, v33, v33, v13
    v_perm_b32 v118, v33, v33, v14
    v_perm_b32 v119, v33, v33, v15
    s_waitcnt vmcnt(5)
    buffer_load_dwordx4 v[76:79], v37, s[8:11], 0 offen nt
    v_xor_b32 v36, s34, v34
    v_readlane_b32 s34, v35, s35
    s_add_u32 s35, s35, 1
    v_mfma_f32_16x16x32_bf16 v[8:11], v[108:111], v[44:47], v[8:11]
    v_mov_b32_dpp v32, v28 row_newbcast:1 row_mask:0xf bank_mask:0xf
    v_perm_b32 v120, v32, v32, v12
    v_perm_b32 v121, v32, v32, v13
    v_perm_b32 v122, v32, v32, v14
    v_perm_b32 v123, v32, v32, v15
    v_mov_b32_dpp v33, v28 row_newbcast:5 row_mask:0xf bank_mask:0xf
    v_perm_b32 v124, v33, v33, v12
    v_perm_b32 v125, v33, v33, v13
    v_perm_b32 v126, v33, v33, v14
    v_perm_b32 v127, v33, v33, v15
    s_waitcnt vmcnt(5)
    buffer_load_dwordx4 v[80:83], v36, s[8:11], 0 offen nt
    v_xor_b32 v37, s34, v34
    v_readlane_b32 s34, v35, s35
    s_add_u32 s35, s35, 1
    v_mfma_f32_16x16x32_bf16 v[8:11], v[112:115], v[48:51], v[8:11]
    v_mov_b32_dpp v32, v28 row_newbcast:9 row_mask:0xf bank_mask:0xf
    v_perm_b32 v128, v32, v32, v12
    v_perm_b32 v129, v32, v32, v13
    v_perm_b32 v130, v32, v32, v14
    v_perm_b32 v131, v32, v32, v15
    v_mov_b32_dpp v33, v28 row_newbcast:13 row_mask:0xf bank_mask:0xf
    v_perm_b32 v132, v33, v33, v12
    v_perm_b32 v133, v33, v33, v13
    v_perm_b32 v134, v33, v33, v14
    v_perm_b32 v135, v33, v33, v15
    s_waitcnt vmcnt(5)
    buffer_load_dwordx4 v[84:87], v37, s[8:11], 0 offen nt
    v_xor_b32 v36, s34, v34
    v_readlane_b32 s34, v35, s35
    s_add_u32 s35, s35, 1
    v_mfma_f32_16x16x32_bf16 v[8:11], v[116:119], v[52:55], v[8:11]
    v_mov_b32_dpp v32, v28 row_newbcast:2 row_mask:0xf bank_mask:0xf
    v_perm_b32 v104, v32, v32, v12
    v_perm_b32 v105, v32, v32, v13
    v_perm_b32 v106, v32, v32, v14
    v_perm_b32 v107, v32, v32, v15
    v_mov_b32_dpp v33, v28 row_newbcast:6 row_mask:0xf bank_mask:0xf
    v_perm_b32 v108, v33, v33, v12
    v_perm_b32 v109, v33, v33, v13
    v_perm_b32 v110, v33, v33, v14
    v_perm_b32 v111, v33, v33, v15
    s_waitcnt vmcnt(5)
    buffer_load_dwordx4 v[88:91], v36, s[8:11], 0 offen nt
    v_xor_b32 v37, s34, v34
    v_readlane_b32 s34, v35, s35
    s_add_u32 s35, s35, 1
    v_mfma_f32_16x16x32_bf16 v[8:11], v[120:123], v[56:59], v[8:11]
    v_mov_b32_dpp v32, v28 row_newbcast:10 row_mask:0xf bank_mask:0xf
    v_perm_b32 v112, v32, v32, v12
    v_perm_b32 v113, v32, v32, v13
    v_perm_b32 v114, v32, v32, v14
    v_perm_b32 v115, v32, v32, v15
    v_mov_b32_dpp v33, v28 row_newbcast:14 row_mask:0xf bank_mask:0xf
    v_perm_b32 v116, v33, v33, v12
    v_perm_b32 v117, v33, v33, v13
    v_perm_b32 v118, v33, v33, v14
    v_perm_b32 v119, v33, v33, v15
    s_waitcnt vmcnt(5)
    buffer_load_dwordx4 v[92:95], v37, s[8:11], 0 offen nt
    v_xor_b32 v36, s34, v34
    v_readlane_b32 s34, v35, s35
    s_add_u32 s35, s35, 1
    v_mfma_f32_16x16x32_bf16 v[8:11], v[124:127], v[60:63], v[8:11]
    v_mov_b32_dpp v32, v28 row_newbcast:3 row_mask:0xf bank_mask:0xf
    v_perm_b32 v120, v32, v32, v12
    v_perm_b32 v121, v32, v32, v13
    v_perm_b32 v122, v32, v32, v14
    v_perm_b32 v123, v32, v32, v15
    v_mov_b32_dpp v33, v28 row_newbcast:7 row_mask:0xf bank_mask:0xf
    v_perm_b32 v124, v33, v33, v12
    v_perm_b32 v125, v33, v33, v13
    v_perm_b32 v126, v33, v33, v14
    v_perm_b32 v127, v33, v33, v15
    s_waitcnt vmcnt(7)
    buffer_load_dwordx4 v[96:99], v36, s[8:11], 0 offen nt
    v_xor_b32 v37, s34, v34
    v_mfma_f32_16x16x32_bf16 v[8:11], v[128:131], v[64:67], v[8:11]
    v_mov_b32_dpp v32, v28 row_newbcast:11 row_mask:0xf bank_mask:0xf
    v_perm_b32 v128, v32, v32, v12
    v_perm_b32 v129, v32, v32, v13
    v_perm_b32 v130, v32, v32, v14
    v_perm_b32 v131, v32, v32, v15
    s_waitcnt vmcnt(7)
    buffer_load_dwordx4 v[100:103], v37, s[8:11], 0 offen nt
    v_mfma_f32_16x16x32_bf16 v[8:11], v[132:135], v[68:71], v[8:11]
    v_mov_b32_dpp v33, v28 row_newbcast:15 row_mask:0xf bank_mask:0xf
    v_perm_b32 v132, v33, v33, v12
    v_perm_b32 v133, v33, v33, v13
    v_perm_b32 v134, v33, v33, v14
    v_perm_b32 v135, v33, v33, v15
    s_waitcnt vmcnt(7)
    s_nop 0
    v_mfma_f32_16x16x32_bf16 v[8:11], v[104:107], v[72:75], v[8:11]
    s_waitcnt vmcnt(6)
    v_mfma_f32_16x16x32_bf16 v[8:11], v[108:111], v[76:79], v[8:11]
    s_waitcnt vmcnt(5)
    v_mfma_f32_16x16x32_bf16 v[8:11], v[112:115], v[80:83], v[8:11]
    s_waitcnt vmcnt(4)
    v_mfma_f32_16x16x32_bf16 v[8:11], v[116:119], v[84:87], v[8:11]
    s_waitcnt vmcnt(3)
    v_mfma_f32_16x16x32_bf16 v[8:11], v[120:123], v[88:91], v[8:11]
    s_waitcnt vmcnt(2)
    v_mfma_f32_16x16x32_bf16 v[8:11], v[124:127], v[92:95], v[8:11]
    s_waitcnt vmcnt(1)
    v_mfma_f32_16x16x32_bf16 v[8:11], v[128:131], v[96:99], v[8:11]
    s_waitcnt vmcnt(0)
    v_mfma_f32_16x16x32_bf16 v[8:11], v[132:135], v[100:103], v[8:11]
    s_nop 7
    v_pk_add_f32 v[8:9], v[8:9], v[10:11]
    ds_write_b64 v1, v[8:9] offset:4096
    s_waitcnt lgkmcnt(0)
    s_barrier
L_end:
    s_endpgm
L_fw:
    s_load_dwordx8 s[12:19], s[0:1], 16
    s_lshr_b32 s21, s2, 6
    s_lshl_b32 s3, s20, 2
    v_mov_b32 v11, s3
    s_or_b32 s27, s3, s21
    v_and_b32 v64, 63, v0
    v_lshlrev_b32 v10, 3, v64
    s_lshl_b32 s3, s27, 9
    v_or_b32 v7, s3, v10
    v_xor_b32 v4, 512, v7
    v_xor_b32 v5, 1024, v7
    v_xor_b32 v6, 1536, v7
    s_lshl_b32 s3, s20, 9
    s_add_u32 s3, s3, 0x20000
    v_and_b32 v65, 3, v0
    v_lshl_add_u32 v8, v65, 7, s3
    v_lshrrev_b32 v64, 4, v64
    v_lshl_add_u32 v9, v64, 2, v2
    s_getreg_b32 s36, hwreg(HW_REG_XCC_ID, 0, 4)
    s_lshl_b32 s36, s36, 1
    s_mov_b32 s22, 0x3e0293ee
    s_waitcnt lgkmcnt(0)
    global_load_dwordx2 v[18:19], v7, s[18:19] sc1
    s_lshl_b64 exec, 1, s21
    global_load_dword v64, v8, s[18:19] sc1
    s_mov_b64 exec, -1
    s_waitcnt vmcnt(0)
    global_load_dwordx2 v[12:13], v4, s[18:19] sc1
    global_load_dwordx2 v[14:15], v5, s[18:19] sc1
    global_load_dwordx2 v[16:17], v6, s[18:19] sc1
    s_waitcnt vmcnt(0)
    global_load_dwordx3 v[20:22], v8, s[18:19] sc1
    v_bfi_b32 v12, v12, 0, 1
    v_bfi_b32 v13, v13, 0, 1
    v_bfi_b32 v14, v14, 0, 1
    v_bfi_b32 v15, v15, 0, 1
    v_bfi_b32 v16, v16, 0, 1
    v_bfi_b32 v17, v17, 0, 1
    v_bfi_b32 v18, v18, 0, 1
    v_bfi_b32 v19, v19, 0, 1
    v_lshlrev_b32 v64, 1, v10
    v_mov_b32 v65, 0
    s_waitcnt vmcnt(0)
    v_bfi_b32 v20, v20, 0, 1
    v_bfi_b32 v21, v21, 0, 1
    v_bfi_b32 v22, v22, 0, 1
    v_or_b32 v20, s36, v20
    s_barrier
    ds_read_b128 v[28:31], v65 offset:6144
    ds_read_b128 v[72:75], v64 offset:0
    ds_read_b128 v[76:79], v64 offset:1024
    ds_read_b128 v[80:83], v64 offset:2048
    ds_read_b128 v[84:87], v64 offset:3072
    s_waitcnt lgkmcnt(0)
    v_max3_f32 v69, v28, v29, v30
    v_max_f32 v69, v69, v31
    v_sub_f32 v28, v28, v69
    v_sub_f32 v29, v29, v69
    v_sub_f32 v30, v30, v69
    v_sub_f32 v31, v31, v69
    v_exp_f32 v28, v28
    v_exp_f32 v29, v29
    v_exp_f32 v30, v30
    v_exp_f32 v31, v31
    v_fma_f32 v72, v72, s22, -v69
    v_fma_f32 v73, v73, s22, -v69
    v_fma_f32 v74, v74, s22, -v69
    v_fma_f32 v75, v75, s22, -v69
    v_fma_f32 v76, v76, s22, -v69
    v_fma_f32 v77, v77, s22, -v69
    v_fma_f32 v78, v78, s22, -v69
    v_fma_f32 v79, v79, s22, -v69
    v_fma_f32 v80, v80, s22, -v69
    v_fma_f32 v81, v81, s22, -v69
    v_fma_f32 v82, v82, s22, -v69
    v_fma_f32 v83, v83, s22, -v69
    v_fma_f32 v84, v84, s22, -v69
    v_fma_f32 v85, v85, s22, -v69
    v_fma_f32 v86, v86, s22, -v69
    v_fma_f32 v87, v87, s22, -v69
    v_exp_f32 v72, v72
    v_exp_f32 v73, v73
    v_exp_f32 v74, v74
    v_exp_f32 v75, v75
    v_exp_f32 v76, v76
    v_exp_f32 v77, v77
    v_exp_f32 v78, v78
    v_exp_f32 v79, v79
    v_exp_f32 v80, v80
    v_exp_f32 v81, v81
    v_exp_f32 v82, v82
    v_exp_f32 v83, v83
    v_exp_f32 v84, v84
    v_exp_f32 v85, v85
    v_exp_f32 v86, v86
    v_exp_f32 v87, v87
    v_pk_add_f32 v[72:73], v[72:73], v[80:81]
    v_pk_add_f32 v[74:75], v[74:75], v[82:83]
    v_pk_add_f32 v[76:77], v[76:77], v[84:85]
    v_pk_add_f32 v[78:79], v[78:79], v[86:87]
    v_pk_add_f32 v[72:73], v[72:73], v[76:77]
    v_pk_add_f32 v[74:75], v[74:75], v[78:79]
    v_pk_add_f32 v[72:73], v[72:73], v[74:75]
    v_add_f32 v70, v72, v73
    s_nop 1
    v_add_f32_dpp v70, v70, v70 row_ror:8 row_mask:0xf bank_mask:0xf
    s_nop 1
    v_add_f32_dpp v70, v70, v70 row_ror:4 row_mask:0xf bank_mask:0xf
    s_nop 1
    v_add_f32_dpp v70, v70, v70 row_ror:2 row_mask:0xf bank_mask:0xf
    s_nop 1
    v_add_f32_dpp v70, v70, v70 row_ror:1 row_mask:0xf bank_mask:0xf
    v_mov_b32 v64, v70
    s_nop 1
    v_permlane32_swap_b32 v64, v70
    v_add_f32 v70, v70, v64
    v_mov_b32 v64, v70
    s_nop 1
    v_permlane16_swap_b32 v64, v70
    v_add_f32 v70, v70, v64
    v_lshl_or_b32 v68, v69, 31, v20
    v_bfi_b32 v69, 1, v21, v69
    v_bfi_b32 v70, 1, v22, v70
    s_lshl_b64 exec, 1, s21
    global_store_dwordx3 v8, v[68:70], s[18:19]
    s_mov_b64 exec, -1
    s_mov_b32 s25, 6
    s_waitcnt vmcnt(0)
L_msg:
    global_load_dwordx3 v[24:26], v8, s[18:19] sc1
    s_waitcnt vmcnt(0)
    v_xor_b32 v56, v24, v20
    v_xor_b32 v57, v25, v21
    v_xor_b32 v58, v26, v22
    v_or_b32 v64, v57, v58
    v_and_or_b32 v64, v64, 1, v56
    v_lshlrev_b32 v64, 1, v64
    v_cmp_ne_u32 vcc, 0, v64
    s_cbranch_vccz L_local
    s_sub_u32 s25, s25, 1
    s_cmp_lg_u32 s25, 0
    s_cbranch_scc1 L_msg
    s_branch L_global
L_local:
    v_lshrrev_b32 v24, 31, v24
    v_bfi_b32 v25, 1, v24, v25
    v_and_b32 v26, -2, v26
    s_nop 0
    v_max_f32_dpp v65, v25, v25 quad_perm:[1,0,3,2] row_mask:0xf bank_mask:0xf
    s_nop 1
    v_max_f32_dpp v65, v65, v65 quad_perm:[2,3,0,1] row_mask:0xf bank_mask:0xf
    v_sub_f32 v64, v25, v65
    v_exp_f32 v64, v64
    s_nop 0
    v_mul_f32 v66, v26, v64
    s_nop 1
    v_add_f32_dpp v66, v66, v66 quad_perm:[1,0,3,2] row_mask:0xf bank_mask:0xf
    s_nop 1
    v_add_f32_dpp v66, v66, v66 quad_perm:[2,3,0,1] row_mask:0xf bank_mask:0xf
    v_rcp_f32 v66, v66
    s_nop 0
    v_mul_f32 v64, v64, v66
    s_xor_b32 s3, s21, 0
    v_readlane_b32 s37, v64, s3
    s_nop 1
    v_mov_b32 v32, s37
    s_xor_b32 s3, s21, 1
    v_readlane_b32 s37, v64, s3
    s_nop 1
    v_mov_b32 v33, s37
    s_xor_b32 s3, s21, 2
    v_readlane_b32 s37, v64, s3
    s_nop 1
    v_mov_b32 v34, s37
    s_xor_b32 s3, s21, 3
    v_readlane_b32 s37, v64, s3
    s_nop 1
    v_mov_b32 v35, s37
    s_barrier
    ds_read_b64 v[36:37], v10 offset:4096
    ds_read_b64 v[38:39], v10 offset:4608
    ds_read_b64 v[40:41], v10 offset:5120
    ds_read_b64 v[42:43], v10 offset:5632
    global_load_dwordx2 v[44:45], v4, s[18:19] sc1
    global_load_dwordx2 v[46:47], v5, s[18:19] sc1
    global_load_dwordx2 v[48:49], v6, s[18:19] sc1
    s_waitcnt lgkmcnt(2)
    v_pk_mul_f32 v[36:37], v[36:37], v[28:29] op_sel_hi:[1,0]
    v_pk_fma_f32 v[36:37], v[38:39], v[28:29], v[36:37] op_sel:[0,1,0] op_sel_hi:[1,1,1]
    s_waitcnt lgkmcnt(0)
    v_pk_fma_f32 v[36:37], v[40:41], v[30:31], v[36:37] op_sel_hi:[1,0,1]
    v_pk_fma_f32 v[36:37], v[42:43], v[30:31], v[36:37] op_sel:[0,1,0] op_sel_hi:[1,1,1]
    v_bfi_b32 v36, 1, v18, v36
    v_bfi_b32 v37, 1, v19, v37
    global_store_dwordx2 v7, v[36:37], s[18:19]
    global_load_dwordx2 v[50:51], v4, s[18:19] sc1
    global_load_dwordx2 v[52:53], v5, s[18:19] sc1
    global_load_dwordx2 v[54:55], v6, s[18:19] sc1
    v_and_b32 v62, -2, v36
    v_and_b32 v63, -2, v37
    v_pk_mul_f32 v[62:63], v[62:63], v[32:33] op_sel_hi:[1,0]
    s_waitcnt vmcnt(4)
    v_xor_b32 v56, v44, v12
    v_xor_b32 v57, v45, v13
    v_xor_b32 v58, v46, v14
    v_xor_b32 v59, v47, v15
    v_xor_b32 v60, v48, v16
    v_xor_b32 v61, v49, v17
    v_or3_b32 v64, v56, v57, v58
    v_or3_b32 v64, v64, v59, v60
    v_bitop3_b32 v64, v64, v61, 1 bitop3:0xa8
    v_cmp_ne_u32 vcc, 0, v64
    s_cbranch_vccz L_final
    s_waitcnt vmcnt(0)
    global_load_dwordx2 v[44:45], v4, s[18:19] sc1
    global_load_dwordx2 v[46:47], v5, s[18:19] sc1
    global_load_dwordx2 v[48:49], v6, s[18:19] sc1
    v_xor_b32 v56, v50, v12
    v_xor_b32 v57, v51, v13
    v_xor_b32 v58, v52, v14
    v_xor_b32 v59, v53, v15
    v_xor_b32 v60, v54, v16
    v_xor_b32 v61, v55, v17
    v_or3_b32 v64, v56, v57, v58
    v_or3_b32 v64, v64, v59, v60
    v_bitop3_b32 v64, v64, v61, 1 bitop3:0xa8
    v_cmp_ne_u32 vcc, 0, v64
    s_cbranch_vccz L_final
    s_waitcnt vmcnt(0)
    v_xor_b32 v56, v44, v12
    v_xor_b32 v57, v45, v13
    v_xor_b32 v58, v46, v14
    v_xor_b32 v59, v47, v15
    v_xor_b32 v60, v48, v16
    v_xor_b32 v61, v49, v17
    v_or3_b32 v64, v56, v57, v58
    v_or3_b32 v64, v64, v59, v60
    v_bitop3_b32 v64, v64, v61, 1 bitop3:0xa8
    v_cmp_ne_u32 vcc, 0, v64
    s_cbranch_vccnz L_fin
L_final:
    v_pk_mul_f32 v[56:57], v[56:57], v[32:33] op_sel:[0,1] op_sel_hi:[1,1]
    v_pk_mul_f32 v[58:59], v[58:59], v[34:35] op_sel_hi:[1,0]
    v_pk_mul_f32 v[60:61], v[60:61], v[34:35] op_sel:[0,1] op_sel_hi:[1,1]
    v_pk_add_f32 v[56:57], v[56:57], v[62:63]
    v_pk_add_f32 v[58:59], v[58:59], v[60:61]
    v_pk_add_f32 v[56:57], v[56:57], v[58:59]
    v_cvt_pk_bf16_f32 v56, v56, v57
    global_store_dword v9, v56, s[14:15]
L_fin:
    s_endpgm
L_global:
    s_lshl_b64 exec, 1, s21
    global_store_dwordx3 v8, v[68:70], s[18:19] sc1
    s_mov_b64 exec, -1
    s_waitcnt vmcnt(0)
    s_barrier
    ds_read_b64 v[36:37], v10 offset:4096
    ds_read_b64 v[38:39], v10 offset:4608
    ds_read_b64 v[40:41], v10 offset:5120
    ds_read_b64 v[42:43], v10 offset:5632
    s_waitcnt lgkmcnt(2)
    v_pk_mul_f32 v[36:37], v[36:37], v[28:29] op_sel_hi:[1,0]
    v_pk_fma_f32 v[36:37], v[38:39], v[28:29], v[36:37] op_sel:[0,1,0] op_sel_hi:[1,1,1]
    s_waitcnt lgkmcnt(0)
    v_pk_fma_f32 v[36:37], v[40:41], v[30:31], v[36:37] op_sel_hi:[1,0,1]
    v_pk_fma_f32 v[36:37], v[42:43], v[30:31], v[36:37] op_sel:[0,1,0] op_sel_hi:[1,1,1]
    v_bfi_b32 v36, 1, v18, v36
    v_bfi_b32 v37, 1, v19, v37
    global_store_dwordx2 v7, v[36:37], s[18:19] sc1
    v_and_b32 v62, -2, v36
    v_and_b32 v63, -2, v37
    s_lshl_b32 s3, 1, s21
    v_mov_b32 v64, s3
    s_waitcnt vmcnt(0)
    s_mov_b64 exec, 1
    global_atomic_or v65, v11, v64, s[16:17] sc0
    s_mov_b64 exec, -1
    s_waitcnt vmcnt(0)
    v_readfirstlane_b32 s37, v65
    global_load_dwordx2 v[44:45], v4, s[18:19] sc1
    global_load_dwordx2 v[46:47], v5, s[18:19] sc1
    global_load_dwordx2 v[48:49], v6, s[18:19] sc1
    s_waitcnt vmcnt(0)
    s_xor_b32 s3, s21, 1
    s_bitcmp0_b32 s37, s3
    s_cbranch_scc1 L_g0
    v_and_b32 v12, 1, v44
    v_and_b32 v13, 1, v45
L_g0:
    s_xor_b32 s3, s21, 2
    s_bitcmp0_b32 s37, s3
    s_cbranch_scc1 L_g1
    v_and_b32 v14, 1, v46
    v_and_b32 v15, 1, v47
L_g1:
    s_xor_b32 s3, s21, 3
    s_bitcmp0_b32 s37, s3
    s_cbranch_scc1 L_g2
    v_and_b32 v16, 1, v48
    v_and_b32 v17, 1, v49
L_g2:
    v_xor_b32 v56, v44, v12
    v_xor_b32 v57, v45, v13
    v_xor_b32 v58, v46, v14
    v_xor_b32 v59, v47, v15
    v_xor_b32 v60, v48, v16
    v_xor_b32 v61, v49, v17
    v_or3_b32 v64, v56, v57, v58
    v_or3_b32 v64, v64, v59, v60
    v_bitop3_b32 v64, v64, v61, 1 bitop3:0xa8
    v_cmp_ne_u32 vcc, 0, v64
    s_cbranch_vccnz L_fin
    global_load_dwordx3 v[24:26], v8, s[18:19] sc1
    s_waitcnt vmcnt(0)
    v_lshrrev_b32 v24, 31, v24
    v_bfi_b32 v25, 1, v24, v25
    v_and_b32 v26, -2, v26
    s_nop 0
    v_max_f32_dpp v65, v25, v25 quad_perm:[1,0,3,2] row_mask:0xf bank_mask:0xf
    s_nop 1
    v_max_f32_dpp v65, v65, v65 quad_perm:[2,3,0,1] row_mask:0xf bank_mask:0xf
    v_sub_f32 v64, v25, v65
    v_exp_f32 v64, v64
    s_nop 0
    v_mul_f32 v66, v26, v64
    s_nop 1
    v_add_f32_dpp v66, v66, v66 quad_perm:[1,0,3,2] row_mask:0xf bank_mask:0xf
    s_nop 1
    v_add_f32_dpp v66, v66, v66 quad_perm:[2,3,0,1] row_mask:0xf bank_mask:0xf
    v_rcp_f32 v66, v66
    s_nop 0
    v_mul_f32 v64, v64, v66
    s_xor_b32 s3, s21, 0
    v_readlane_b32 s37, v64, s3
    s_nop 1
    v_mov_b32 v32, s37
    s_xor_b32 s3, s21, 1
    v_readlane_b32 s37, v64, s3
    s_nop 1
    v_mov_b32 v33, s37
    s_xor_b32 s3, s21, 2
    v_readlane_b32 s37, v64, s3
    s_nop 1
    v_mov_b32 v34, s37
    s_xor_b32 s3, s21, 3
    v_readlane_b32 s37, v64, s3
    s_nop 1
    v_mov_b32 v35, s37
    v_pk_mul_f32 v[62:63], v[62:63], v[32:33] op_sel_hi:[1,0]
    s_branch L_final
.section .rodata,"a"
.p2align 6
.amdhsa_kernel standalone__mha_softmax__decode_kernel
  .amdhsa_next_free_vgpr 136
  .amdhsa_next_free_sgpr 48
  .amdhsa_accum_offset 136
  .amdhsa_group_segment_fixed_size 0
  .amdhsa_kernarg_size 48
  .amdhsa_user_sgpr_count 2
  .amdhsa_user_sgpr_kernarg_segment_ptr 1
  .amdhsa_system_sgpr_workgroup_id_x 1
  .amdhsa_float_denorm_mode_32 3
.end_amdhsa_kernel
```
